```python
import torch

def _softmax(x, axis=-1):
    return torch.softmax(x, dim=axis)
def _gelu(x):
    return torch.nn.functional.gelu(x, approximate="tanh")
def _silu(x):
    return torch.nn.functional.silu(x)
def _sigmoid(x):
    return torch.sigmoid(x)
def _layernorm(x, axis=-1, eps=1e-5):
    m = x.mean(dim=axis, keepdim=True)
    v = x.var(dim=axis, keepdim=True, unbiased=False)
    return (x - m) / torch.sqrt(v + eps)
def _scatter_add(tgt, idx, src, axis=0):
    return tgt.clone().index_add_(axis, idx, src)
def _segment_sum(src, seg, n):
    out = torch.zeros((n,) + src.shape[1:], dtype=src.dtype)
    return out.index_add_(0, seg, src)
def _pad(x, pw):
    flat = tuple(v for pair in reversed(pw) for v in pair)
    return torch.nn.functional.pad(x, flat)

kernel_name = 'standalone__paged_block_table_kv_pagedattention__decode'

def setup_inputs():

    _w = (lambda a: (lambda t: t.to(torch.bfloat16) if t.is_floating_point() else t)(torch.as_tensor(a)))
    B, Hq, Hkv, Sq, Skv, D = 1, 32, 8, 1, 32768, 128
    bs = 16
    nbps = max(1, Skv // bs)
    num_phys = B * nbps + 4
    bt = torch.randperm(num_phys)[: B * nbps].reshape(B, nbps).to(torch.int64)
    cl = (nbps * bs - (torch.arange(1, B + 1, dtype=torch.int64) * 2654435761) % max(1, nbps * bs // 2)).to(torch.int64)
    return {
        "q": _w((lambda *s: torch.randn(*s, dtype=torch.bfloat16) * 0.8)(B, Hq, Sq, D)),
        "k_cache": _w((lambda *s: torch.randn(*s, dtype=torch.bfloat16) * 0.8)(num_phys, bs, Hkv, D)),
        "v_cache": _w((lambda *s: torch.randn(*s, dtype=torch.bfloat16) * 0.05)(num_phys, bs, Hkv, D)),
        "block_table": _w(bt),
        "context_lens": _w(cl),
    }

def reference(q, k_cache, v_cache, block_table, context_lens):
    B, Hq, Sq, D = q.shape
    bs = k_cache.shape[1]
    Hkv = k_cache.shape[2]
    nbps = block_table.shape[1]
    Skv = nbps * bs
    bt = block_table.reshape(-1)
    k = (lambda x, *d: x.permute(*d))(k_cache[bt].reshape(B, Skv, Hkv, D), 0, 2, 1, 3)
    v = (lambda x, *d: x.permute(*d))(v_cache[bt].reshape(B, Skv, Hkv, D), 0, 2, 1, 3)
    g = Hq // Hkv
    qg = q.reshape(B, Hkv, g, Sq, D)
    scores = torch.einsum("bhgqd,bhkd->bhgqk", qg, k) * (D ** -0.5)
    pos = torch.arange(Skv)
    msk = pos[None, :] < context_lens[:, None]
    scores = torch.where(msk[:, None, None, None, :], scores, -1e9)
    p = _softmax(scores, axis=-1)
    out = torch.einsum("bhgqk,bhkd->bhgqd", p, v)
    return out.reshape(B, Hq, Sq, D)
```

```asm
; @launch grid=(256,1,1) block=(576,1,1) lds=92160
.amdgcn_target "amdgcn-amd-amdhsa--gfx950"
.text
.globl standalone__paged_block_table_kv_pagedattention__decode_kernel
.p2align 8
.type standalone__paged_block_table_kv_pagedattention__decode_kernel,@function
standalone__paged_block_table_kv_pagedattention__decode_kernel:
  s_cmp_ge_u32 s2, 256
  s_cbranch_scc1 L_end1
  s_load_dwordx16 s[16:31], s[0:1], 0
  v_and_b32 v1, 63, v0
  v_lshrrev_b32 v2, 6, v0
  s_cmp_ge_u32 s2, 128
  v_readfirstlane_b32 s3, v2
  s_cselect_b32 s52, 128, 0
  s_cselect_b32 s4, 4, 0
  s_sub_u32 s5, s2, s52
  s_mov_b32 s12, 0
  s_mov_b32 s6, 37
  s_cmp_ge_u32 s5, 37
  s_cselect_b32 s12, 37, s12
  s_cselect_b32 s6, 30, s6
  s_addc_u32 s4, s4, 0
  s_cmp_ge_u32 s5, 67
  s_cselect_b32 s12, 67, s12
  s_cselect_b32 s6, 31, s6
  s_addc_u32 s4, s4, 0
  s_cmp_ge_u32 s5, 98
  s_cselect_b32 s12, 98, s12
  s_cselect_b32 s6, 30, s6
  s_addc_u32 s4, s4, 0
  s_sub_u32 s5, s5, s12
  s_add_u32 s52, s52, s12
  s_mul_i32 s11, s6, s3
  s_add_u32 s11, s11, s5
  s_mul_i32 s15, s6, 8
  v_mul_u32_u24 v8, s15, v1
  v_add_u32 v8, s11, v8
  v_and_b32 v7, -4, v8
  s_mov_b32 s9, s11
  s_and_b32 s70, s9, -4
  s_add_u32 s9, s9, s15
  s_and_b32 s71, s9, -4
  s_add_u32 s9, s9, s15
  s_and_b32 s72, s9, -4
  s_add_u32 s9, s9, s15
  s_and_b32 s73, s9, -4
  v_lshrrev_b32 v11, 4, v1
  v_and_b32 v3, 3, v1
  v_bfe_u32 v4, v1, 2, 2
  v_lshl_add_u32 v5, v11, 2, v3
  v_lshlrev_b32 v5, 4, v5
  v_lshl_add_u32 v16, v4, 8, v5
  v_lshl_add_u32 v5, v4, 11, v5
  v_and_b32 v6, 15, v1
  v_lshlrev_b32 v6, 4, v6
  v_lshl_add_u32 v6, v11, 11, v6
  s_mov_b32 s42, 8192
  s_mov_b32 s43, 0x20000
  s_mov_b32 s38, 8192
  s_mov_b32 s39, 0x20000
  s_mov_b32 s46, 1179648
  s_mov_b32 s47, 0x20000
  s_mov_b32 s35, 0x20000
  s_waitcnt lgkmcnt(0)
  s_cmp_lg_u32 s3, 8
  s_cbranch_scc1 L_notouch
  s_mov_b32 s44, s30
  s_and_b32 s45, s31, 0xffff
  s_add_u32 s65, s52, s5
  s_mul_i32 s65, s65, 4608
  v_lshlrev_b32 v40, 4, v1
  s_add_u32 s12, s65, 4096
  buffer_load_dwordx4 v[44:47], v40, s[44:47], s65 offen offset:0 sc1
  buffer_load_dwordx4 v[44:47], v40, s[44:47], s65 offen offset:1024 sc1
  buffer_load_dwordx4 v[44:47], v40, s[44:47], s65 offen offset:2048 sc1
  buffer_load_dwordx4 v[44:47], v40, s[44:47], s65 offen offset:3072 sc1
  s_mov_b64 exec, 0xff
  buffer_load_dwordx4 v[44:47], v40, s[44:47], s12 offen sc1
  s_mov_b64 exec, -1
L_notouch:
  s_load_dword s7, s[24:25], 0
  s_load_dword s48, s[22:23], s70
  s_load_dword s49, s[22:23], s71
  s_load_dword s50, s[22:23], s72
  s_load_dword s51, s[22:23], s73
  s_mov_b32 s40, s22
  s_and_b32 s41, s23, 0xffff
  buffer_load_dword v2, v7, s[40:43], 0 offen
  s_lshr_b32 s12, s18, 7
  s_sub_u32 s12, 3, s12
  s_lshr_b32 s12, s12, 1
  s_add_u32 s12, s12, s4
  s_and_b32 s12, s12, 3
  s_and_b32 s4, s4, 4
  s_or_b32 s4, s4, s12
  s_mov_b32 s36, s16
  s_and_b32 s37, s17, 0xffff
  s_lshl_b32 s12, s4, 10
  buffer_load_dwordx4 v[16:19], v16, s[36:39], s12 offen
  s_mov_b32 s44, s30
  s_and_b32 s45, s31, 0xffff
  s_add_u32 s65, s52, s5
  s_mul_i32 s65, s65, 4608
  s_cmp_eq_u32 s3, 8
  s_cbranch_scc1 L_service
  s_mov_b32 s32, s18
  s_and_b32 s33, s19, 0xffff
  v_mov_b32 v7, v5
  s_lshl_b32 s64, s4, 8
  s_lshl_b32 s14, s11, 2
  s_waitcnt lgkmcnt(0)
  s_min_i32 s7, s7, 0x8000
  s_cmp_lt_i32 s7, 1
  s_cselect_b32 s7, 0x8000, s7
  s_cselect_b32 s13, 0, -1
  s_add_u32 s9, s7, 3
  s_lshr_b32 s9, s9, 2
  s_min_u32 s48, s48, 2051
  s_lshl_b32 s48, s48, 15
  s_and_b32 s12, s11, 3
  s_lshl_b32 s12, s12, 13
  s_add_u32 s12, s12, s64
  s_add_u32 s48, s48, s12
  s_cmp_lt_u32 s11, s9
  s_cselect_b32 s34, 0x4020000, 0
  s_cselect_b32 s48, s48, 0
  s_add_u32 s11, s11, s15
  buffer_load_dwordx4 v[32:35], v7, s[32:35], s48 offen nt
  s_min_u32 s49, s49, 2051
  s_lshl_b32 s49, s49, 15
  s_and_b32 s12, s11, 3
  s_lshl_b32 s12, s12, 13
  s_add_u32 s12, s12, s64
  s_add_u32 s49, s49, s12
  s_cmp_lt_u32 s11, s9
  s_cselect_b32 s34, 0x4020000, 0
  s_cselect_b32 s49, s49, 0
  s_add_u32 s11, s11, s15
  buffer_load_dwordx4 v[36:39], v7, s[32:35], s49 offen nt
  s_min_u32 s50, s50, 2051
  s_lshl_b32 s50, s50, 15
  s_and_b32 s12, s11, 3
  s_lshl_b32 s12, s12, 13
  s_add_u32 s12, s12, s64
  s_add_u32 s50, s50, s12
  s_cmp_lt_u32 s11, s9
  s_cselect_b32 s34, 0x4020000, 0
  s_cselect_b32 s50, s50, 0
  s_add_u32 s11, s11, s15
  buffer_load_dwordx4 v[40:43], v7, s[32:35], s50 offen nt
  s_min_u32 s51, s51, 2051
  s_lshl_b32 s51, s51, 15
  s_and_b32 s12, s11, 3
  s_lshl_b32 s12, s12, 13
  s_add_u32 s12, s12, s64
  s_add_u32 s51, s51, s12
  s_cmp_lt_u32 s11, s9
  s_cselect_b32 s34, 0x4020000, 0
  s_cselect_b32 s51, s51, 0
  s_add_u32 s11, s11, s15
  buffer_load_dwordx4 v[44:47], v7, s[32:35], s51 offen nt
  v_cmp_gt_u32 vcc, s9, v8
  s_sub_i32 s14, s7, s14
  s_lshl_b32 s15, s15, 2
  s_bcnt1_i32_b64 s8, vcc
  s_add_u32 s9, s8, 3
  s_lshr_b32 s9, s9, 2
  s_max_u32 s9, s9, 1
  v_and_b32 v8, 3, v8
  v_lshlrev_b32 v8, 13, v8
  v_add_u32 v8, s64, v8
  s_mov_b32 s11, 4
  s_waitcnt vmcnt(5)
  v_min_u32 v2, 2051, v2
  v_lshl_add_u32 v8, v2, 15, v8
  v_and_b32 v9, 1, v1
  v_lshlrev_b32 v9, 4, v9
  s_mov_b32 s12, 0xffff
  v_lshlrev_b32 v9, v9, s12
  v_cmp_gt_u32 vcc, 2, v3
  v_mov_b32 v15, 0
  v_mov_b32 v13, 0xe0ad78ec
  v_cndmask_b32 v10, v9, v15, vcc
  v_cndmask_b32 v9, v15, v9, vcc
  v_mov_b32 v12, 0xf149f2ca
  v_mul_u32_u24 v28, 32, v4
  s_lshl_b32 s12, s3, 2
  v_add_u32 v28, s12, v28
  s_mul_i32 s12, s3, 2112
  s_add_u32 s12, s12, 512
  v_lshlrev_b32 v30, 4, v1
  v_add_u32 v30, s12, v30
  v_lshlrev_b32 v31, 3, v4
  v_add_u32 v31, s12, v31
  s_mul_i32 s64, s3, 7104
  s_add_u32 s64, s64, 16896
  v_add_u32 v29, s64, v30
  s_mov_b32 s10, 0x3e0293ee
  v_mov_b32 v20, 0
  v_mov_b32 v21, 0
  v_mov_b32 v22, 0
  v_mov_b32 v23, 0
  v_mov_b32 v24, 0
  v_mov_b32 v25, 0
  v_mov_b32 v26, 0
  v_mov_b32 v27, 0
  v_bfe_u32 v71, v0, 3, 2
  v_mul_u32_u24 v69, 32, v71
  v_lshlrev_b32 v68, 3, v0
  v_lshrrev_b32 v70, 5, v0
  v_lshlrev_b32 v70, 3, v70
  v_and_or_b32 v70, v0, 7, v70
  v_lshl_add_u32 v70, v71, 6, v70
  v_lshlrev_b32 v70, 4, v70
  s_cmp_eq_u32 s3, 4
  s_cselect_b64 s[66:67], -1, 0
  s_cselect_b32 s68, 0x01010101, -1
  s_cselect_b32 s69, 0, -1
  v_lshlrev_b32 v2, 3, v71
  v_add_u32 v2, 2048, v2
  v_cndmask_b32 v68, v68, v2, s[66:67]
  v_lshlrev_b32 v2, 4, v71
  v_add_u32 v2, 4096, v2
  v_cndmask_b32 v70, v70, v2, s[66:67]
  v_mov_b32 v71, 128
  s_waitcnt vmcnt(4)
  v_and_b32 v16, s13, v16
  v_and_b32 v17, s13, v17
  v_and_b32 v18, s13, v18
  v_and_b32 v19, s13, v19
  s_mov_b32 s53, s9
L_kloop:
  s_sub_u32 s53, s53, 1
  s_cmp_lg_u32 s53, 0
  s_cbranch_scc1 L_noswitch
  s_mov_b32 s32, s20
  s_and_b32 s33, s21, 0xffff
  v_mov_b32 v7, v6
  s_mov_b32 s11, 0
L_noswitch:
  v_readlane_b32 s48, v8, s11
  s_add_u32 s12, s11, 1
  v_readlane_b32 s49, v8, s12
  s_add_u32 s12, s11, 2
  v_readlane_b32 s50, v8, s12
  s_add_u32 s12, s11, 3
  v_readlane_b32 s51, v8, s12
  s_waitcnt vmcnt(3)
  v_mfma_f32_16x16x32_bf16 v[48:51], v[32:35], v[16:19], 0
  s_cmp_lt_u32 s11, s8
  s_cselect_b32 s34, 0x4020000, 0
  s_cselect_b32 s48, s48, 0
  s_add_u32 s11, s11, 1
  buffer_load_dwordx4 v[32:35], v7, s[32:35], s48 offen nt
  s_waitcnt vmcnt(3)
  v_mfma_f32_16x16x32_bf16 v[52:55], v[36:39], v[16:19], 0
  s_cmp_lt_u32 s11, s8
  s_cselect_b32 s34, 0x4020000, 0
  s_cselect_b32 s49, s49, 0
  s_add_u32 s11, s11, 1
  buffer_load_dwordx4 v[36:39], v7, s[32:35], s49 offen nt
  s_waitcnt vmcnt(3)
  v_mfma_f32_16x16x32_bf16 v[56:59], v[40:43], v[16:19], 0
  s_cmp_lt_u32 s11, s8
  s_cselect_b32 s34, 0x4020000, 0
  s_cselect_b32 s50, s50, 0
  s_add_u32 s11, s11, 1
  buffer_load_dwordx4 v[40:43], v7, s[32:35], s50 offen nt
  s_waitcnt vmcnt(3)
  v_mfma_f32_16x16x32_bf16 v[60:63], v[44:47], v[16:19], 0
  s_cmp_lt_u32 s11, s8
  s_cselect_b32 s34, 0x4020000, 0
  s_cselect_b32 s51, s51, 0
  s_add_u32 s11, s11, 1
  buffer_load_dwordx4 v[44:47], v7, s[32:35], s51 offen nt
  v_cmp_gt_i32 s[70:71], s14, v11
  s_sub_i32 s14, s14, s15
  v_cmp_gt_i32 s[72:73], s14, v11
  s_sub_i32 s14, s14, s15
  v_cmp_gt_i32 s[74:75], s14, v11
  s_sub_i32 s14, s14, s15
  v_cmp_gt_i32 s[76:77], s14, v11
  s_sub_i32 s14, s14, s15
  v_mov_b32_dpp v64, v48 quad_perm:[0,0,0,0] row_mask:0xf bank_mask:0xf
  v_mov_b32_dpp v65, v52 quad_perm:[0,0,0,0] row_mask:0xf bank_mask:0xf
  v_mov_b32_dpp v66, v56 quad_perm:[0,0,0,0] row_mask:0xf bank_mask:0xf
  v_mov_b32_dpp v67, v60 quad_perm:[0,0,0,0] row_mask:0xf bank_mask:0xf
  v_add_f32_dpp v64, v49, v64 quad_perm:[1,1,1,1] row_mask:0xf bank_mask:0xf
  v_add_f32_dpp v65, v53, v65 quad_perm:[1,1,1,1] row_mask:0xf bank_mask:0xf
  v_add_f32_dpp v66, v57, v66 quad_perm:[1,1,1,1] row_mask:0xf bank_mask:0xf
  v_add_f32_dpp v67, v61, v67 quad_perm:[1,1,1,1] row_mask:0xf bank_mask:0xf
  v_add_f32_dpp v64, v50, v64 quad_perm:[2,2,2,2] row_mask:0xf bank_mask:0xf
  v_add_f32_dpp v65, v54, v65 quad_perm:[2,2,2,2] row_mask:0xf bank_mask:0xf
  v_add_f32_dpp v66, v58, v66 quad_perm:[2,2,2,2] row_mask:0xf bank_mask:0xf
  v_add_f32_dpp v67, v62, v67 quad_perm:[2,2,2,2] row_mask:0xf bank_mask:0xf
  v_add_f32_dpp v64, v51, v64 quad_perm:[3,3,3,3] row_mask:0xf bank_mask:0xf
  v_add_f32_dpp v65, v55, v65 quad_perm:[3,3,3,3] row_mask:0xf bank_mask:0xf
  v_add_f32_dpp v66, v59, v66 quad_perm:[3,3,3,3] row_mask:0xf bank_mask:0xf
  v_add_f32_dpp v67, v63, v67 quad_perm:[3,3,3,3] row_mask:0xf bank_mask:0xf
  v_cndmask_b32 v64, v12, v64, s[70:71]
  v_cndmask_b32 v65, v12, v65, s[72:73]
  v_cndmask_b32 v66, v12, v66, s[74:75]
  v_cndmask_b32 v67, v12, v67, s[76:77]
  v_max3_f32 v13, v13, v64, v65
  v_max3_f32 v13, v13, v66, v67
  ds_write_b128 v29, v[64:67] offset:0
  v_add_u32 v29, 1024, v29
  s_cmp_lg_u32 s53, 0
  s_cbranch_scc1 L_kloop
  v_mov_b32 v3, v13
  v_add_u32 v29, s64, v30
  s_waitcnt lgkmcnt(0)
  v_permlane32_swap_b32 v13, v3
  ds_read_b128 v[64:67], v29 offset:0
  s_nop 0
  v_max_f32 v13, v13, v3
  v_mov_b32 v3, v13
  s_nop 1
  v_permlane16_swap_b32 v13, v3
  s_nop 1
  v_max_f32 v13, v13, v3
  v_mul_f32 v14, s10, v13
  s_mov_b32 s53, s9
  ds_write_b32 v28, v14
  v_bfe_u32 v2, v1, 2, 2
  v_mul_u32_u24 v2, 32, v2
  s_waitcnt lgkmcnt(0)
  s_barrier
  ds_read_b128 v[48:51], v2 offset:0
  ds_read_b128 v[52:55], v2 offset:16
  s_waitcnt lgkmcnt(0)
  v_max3_f32 v14, v48, v49, v50
  v_max3_f32 v14, v14, v51, v52
  v_max3_f32 v14, v14, v53, v54
  v_max_f32 v14, v14, v55
  ds_read_b128 v[48:51], v69 offset:0
  ds_read_b128 v[52:55], v69 offset:16
  s_waitcnt lgkmcnt(0)
  v_max3_f32 v13, v48, v49, v50
  v_max3_f32 v13, v13, v51, v52
  v_max3_f32 v13, v13, v53, v54
  v_max_f32 v13, v13, v55
L_vloop:
  v_readlane_b32 s48, v8, s11
  s_add_u32 s12, s11, 1
  v_readlane_b32 s49, v8, s12
  s_add_u32 s12, s11, 2
  v_readlane_b32 s50, v8, s12
  s_add_u32 s12, s11, 3
  v_readlane_b32 s51, v8, s12
  v_add_u32 v29, 1024, v29
  s_waitcnt lgkmcnt(0)
  v_fma_f32 v50, v64, s10, -v14
  v_fma_f32 v54, v65, s10, -v14
  v_fma_f32 v58, v66, s10, -v14
  v_fma_f32 v62, v67, s10, -v14
  ds_read_b128 v[64:67], v29 offset:0
  v_exp_f32 v50, v50
  v_exp_f32 v54, v54
  v_exp_f32 v58, v58
  v_exp_f32 v62, v62
  s_sub_u32 s53, s53, 1
  v_add_f32 v15, v15, v50
  v_cvt_pk_bf16_f32 v50, v50, v50
  v_add_f32 v15, v15, v54
  v_cvt_pk_bf16_f32 v54, v54, v54
  v_add_f32 v15, v15, v58
  v_cvt_pk_bf16_f32 v58, v58, v58
  v_add_f32 v15, v15, v62
  v_cvt_pk_bf16_f32 v62, v62, v62
  v_mov_b32 v2, v15
  v_mov_b32 v3, v15
  v_and_b32 v48, v50, v9
  v_and_b32 v49, v50, v10
  v_permlane32_swap_b32 v2, v3
  v_and_b32 v52, v54, v9
  v_and_b32 v53, v54, v10
  v_add_f32 v2, v2, v3
  v_mov_b32 v3, v2
  v_and_b32 v56, v58, v9
  v_and_b32 v57, v58, v10
  v_permlane16_swap_b32 v2, v3
  v_and_b32 v60, v62, v9
  v_and_b32 v61, v62, v10
  v_add_f32 v2, v2, v3
  ds_write_b32 v31, v2 offset:2052
  s_waitcnt vmcnt(3)
  v_mfma_f32_16x16x16_bf16 v[20:23], v[32:33], v[48:49], v[20:23]
  v_mfma_f32_16x16x16_bf16 v[24:27], v[34:35], v[48:49], v[24:27]
  s_cmp_lt_u32 s11, s8
  s_cselect_b32 s34, 0x4020000, 0
  s_cselect_b32 s48, s48, 0
  s_add_u32 s11, s11, 1
  buffer_load_dwordx4 v[32:35], v7, s[32:35], s48 offen nt
  s_waitcnt vmcnt(3)
  v_mfma_f32_16x16x16_bf16 v[20:23], v[36:37], v[52:53], v[20:23]
  v_mfma_f32_16x16x16_bf16 v[24:27], v[38:39], v[52:53], v[24:27]
  s_cmp_lt_u32 s11, s8
  s_cselect_b32 s34, 0x4020000, 0
  s_cselect_b32 s49, s49, 0
  s_add_u32 s11, s11, 1
  buffer_load_dwordx4 v[36:39], v7, s[32:35], s49 offen nt
  s_waitcnt vmcnt(3)
  v_mfma_f32_16x16x16_bf16 v[20:23], v[40:41], v[56:57], v[20:23]
  v_mfma_f32_16x16x16_bf16 v[24:27], v[42:43], v[56:57], v[24:27]
  s_cmp_lt_u32 s11, s8
  s_cselect_b32 s34, 0x4020000, 0
  s_cselect_b32 s50, s50, 0
  s_add_u32 s11, s11, 1
  buffer_load_dwordx4 v[40:43], v7, s[32:35], s50 offen nt
  s_waitcnt vmcnt(3)
  v_mfma_f32_16x16x16_bf16 v[20:23], v[44:45], v[60:61], v[20:23]
  v_mfma_f32_16x16x16_bf16 v[24:27], v[46:47], v[60:61], v[24:27]
  s_cmp_lt_u32 s11, s8
  s_cselect_b32 s34, 0x4020000, 0
  s_cselect_b32 s51, s51, 0
  s_add_u32 s11, s11, 1
  buffer_load_dwordx4 v[44:47], v7, s[32:35], s51 offen nt
  s_cmp_lg_u32 s53, 0
  s_cbranch_scc1 L_vloop
  s_nop 0
  ds_write_b128 v30, v[20:23]
  ds_write_b128 v30, v[24:27] offset:1024
  s_waitcnt lgkmcnt(0)
  s_barrier
  s_cmp_gt_u32 s3, 4
  s_cbranch_scc1 L_fin1
L_merge:
  ds_read_b64 v[18:19], v71
  ds_read_b64 v[72:73], v68 offset:512
  ds_read_b64 v[74:75], v68 offset:2624
  ds_read_b64 v[76:77], v68 offset:4736
  ds_read_b64 v[78:79], v68 offset:6848
  ds_read_b64 v[80:81], v68 offset:8960
  ds_read_b64 v[82:83], v68 offset:11072
  ds_read_b64 v[84:85], v68 offset:13184
  ds_read_b64 v[86:87], v68 offset:15296
  v_mov_b32 v14, v13
  s_waitcnt lgkmcnt(6)
  v_pk_add_f32 v[16:17], v[72:73], v[74:75]
  s_waitcnt lgkmcnt(5)
  v_pk_add_f32 v[16:17], v[16:17], v[76:77]
  s_waitcnt lgkmcnt(4)
  v_pk_add_f32 v[16:17], v[16:17], v[78:79]
  s_waitcnt lgkmcnt(3)
  v_pk_add_f32 v[16:17], v[16:17], v[80:81]
  s_waitcnt lgkmcnt(2)
  v_pk_add_f32 v[16:17], v[16:17], v[82:83]
  s_waitcnt lgkmcnt(1)
  v_pk_add_f32 v[16:17], v[16:17], v[84:85]
  s_waitcnt lgkmcnt(0)
  v_pk_add_f32 v[16:17], v[16:17], v[86:87]
  s_cmp_lg_u32 s53, 0
  v_cndmask_b32 v16, v16, v14, s[66:67]
  s_cbranch_scc1 L_dry1
  s_mov_b64 exec, s[68:69]
  buffer_store_dwordx4 v[16:19], v70, s[44:47], s65 offen sc1
  s_branch L_fin1
L_service:
  s_memrealtime s[60:61]
  s_mov_b32 s36, s28
  s_and_b32 s37, s29, 0xffff
  s_mov_b32 s38, 256
  s_mov_b32 s39, 0x20000
  s_lshl_b32 s64, s4, 5
  v_mov_b32 v34, 0
  v_mov_b32 v35, 0
  s_waitcnt lgkmcnt(0) vmcnt(0)
  s_or_b32 s60, s60, 1
  v_mov_b32 v32, s60
  v_mov_b32 v33, s61
  s_mov_b64 exec, 1
  s_cmp_eq_u32 s5, 0
  s_cbranch_scc1 L_cas
  s_mov_b32 s12, 16
  s_barrier
  s_branch L_nread1
L_nread:
  s_sleep 16
L_nread1:
  buffer_load_dwordx2 v[36:37], off, s[36:39], s64 sc1
  s_waitcnt vmcnt(0)
  v_cmp_ne_u64 vcc, 0, v[36:37]
  s_sub_u32 s12, s12, 1
  s_nop 3
  s_cbranch_vccnz L_ngot
  s_cmp_lg_u32 s12, 0
  s_cbranch_scc1 L_nread
L_cas:
  buffer_atomic_cmpswap_x2 v[32:35], off, s[36:39], s64 sc0 sc1
  s_waitcnt vmcnt(0)
  v_cmp_eq_u64 vcc, 0, v[32:33]
  v_mov_b32 v34, s60
  v_mov_b32 v35, s61
  v_cndmask_b32 v36, v32, v34, vcc
  v_cndmask_b32 v37, v33, v35, vcc
  s_cmp_lg_u32 s5, 0
  s_cbranch_scc1 L_ngot
  s_barrier
L_ngot:
  v_mov_b32 v34, 128
  ds_write_b64 v34, v[36:37]
  v_readfirstlane_b32 s60, v36
  v_readfirstlane_b32 s61, v37
  s_mov_b64 exec, -1
  s_mov_b32 s53, 1
L_dry1:
  v_lshrrev_b32 v5, 4, v1
  v_and_b32 v6, 15, v1
  s_and_b32 s7, s5, 15
  s_lshl_b32 s12, s7, 8
  s_lshr_b32 s13, s7, 2
  s_mul_i32 s11, s52, 4608
  s_add_u32 s12, s12, s11
  s_lshl_b32 s8, s13, 4
  s_add_u32 s8, s8, s11
  s_add_u32 s8, s8, 4096
  s_sub_u32 s9, s6, 1
  s_mov_b32 s14, 4608
  v_add_u32 v9, 0, v5
  v_mul_lo_u32 v9, v9, s14
  v_add_u32 v10, 4, v5
  v_mul_lo_u32 v10, v10, s14
  v_add_u32 v11, 8, v5
  v_mul_lo_u32 v11, v11, s14
  v_add_u32 v12, 12, v5
  v_mul_lo_u32 v12, v12, s14
  v_add_u32 v13, 16, v5
  v_mul_lo_u32 v13, v13, s14
  v_add_u32 v14, 20, v5
  v_mul_lo_u32 v14, v14, s14
  v_add_u32 v15, 24, v5
  v_mul_lo_u32 v15, v15, s14
  v_add_u32 v16, 28, v5
  v_min_u32 v16, s9, v16
  v_mul_lo_u32 v16, v16, s14
  v_add_u32 v17, 32, v5
  v_min_u32 v17, s9, v17
  v_mul_lo_u32 v17, v17, s14
  v_add_u32 v18, 36, v5
  v_min_u32 v18, s9, v18
  v_mul_lo_u32 v18, v18, s14
  v_lshlrev_b32 v7, 4, v6
  v_add_u32 v20, v9, v7
  v_add_u32 v21, v10, v7
  v_add_u32 v22, v11, v7
  v_add_u32 v23, v12, v7
  v_add_u32 v24, v13, v7
  v_add_u32 v25, v14, v7
  v_add_u32 v26, v15, v7
  v_add_u32 v27, v16, v7
  v_add_u32 v28, v17, v7
  v_add_u32 v29, v18, v7
  s_and_b32 s15, s7, 1
  s_lshl_b32 s15, s15, 6
  s_bfe_u32 s10, s7, 0x10001
  s_lshl_b32 s10, s10, 2
  s_add_u32 s15, s15, s10
  s_lshl_b32 s10, s4, 2
  s_add_u32 s10, s10, s13
  s_lshl_b32 s10, s10, 7
  s_add_u32 s15, s15, s10
  s_lshl_b32 s15, s15, 1
  v_bfe_u32 v7, v6, 1, 2
  v_lshrrev_b32 v8, 3, v6
  v_lshl_add_u32 v7, v8, 5, v7
  v_and_b32 v8, 1, v6
  v_lshl_add_u32 v7, v8, 4, v7
  v_lshlrev_b32 v7, 1, v7
  s_mov_b32 s56, s26
  s_and_b32 s57, s27, 0xffff
  s_mov_b32 s58, 8192
  s_mov_b32 s59, 0x20000
  v_add_u32 v6, 28, v5
  v_cmp_gt_u32 s[48:49], s6, v6
  v_add_u32 v6, 32, v5
  v_cmp_gt_u32 s[50:51], s6, v6
  v_add_u32 v6, 36, v5
  v_cmp_gt_u32 s[40:41], s6, v6
  v_mov_b32 v8, 0xf149f2ca
  s_mov_b32 s7, 20000
  s_mov_b64 s[66:67], -1
  s_mov_b64 s[68:69], -1
  s_mov_b64 s[70:71], -1
  s_mov_b64 s[72:73], -1
  s_mov_b64 s[74:75], -1
  s_mov_b64 s[76:77], -1
  s_mov_b64 s[78:79], -1
  s_mov_b64 s[80:81], -1
  s_mov_b64 s[82:83], -1
  s_mov_b64 s[84:85], -1
L_dry2:
  s_mov_b32 s53, 0
  s_waitcnt lgkmcnt(0)
  s_barrier
  s_cmp_ge_u32 s5, 16
  s_cbranch_scc1 L_fin1
L_poll:
  s_sub_u32 s7, s7, 1
  s_cmp_eq_u32 s7, 0
  s_cbranch_scc1 L_fin1
  s_mov_b64 exec, s[66:67]
  buffer_load_dwordx4 v[72:75], v9, s[44:47], s8 offen sc1
  buffer_load_dwordx4 v[32:35], v20, s[44:47], s12 offen sc1
  s_mov_b64 exec, s[68:69]
  buffer_load_dwordx4 v[76:79], v10, s[44:47], s8 offen sc1
  buffer_load_dwordx4 v[36:39], v21, s[44:47], s12 offen sc1
  s_mov_b64 exec, s[70:71]
  buffer_load_dwordx4 v[80:83], v11, s[44:47], s8 offen sc1
  buffer_load_dwordx4 v[40:43], v22, s[44:47], s12 offen sc1
  s_mov_b64 exec, s[72:73]
  buffer_load_dwordx4 v[84:87], v12, s[44:47], s8 offen sc1
  buffer_load_dwordx4 v[44:47], v23, s[44:47], s12 offen sc1
  s_mov_b64 exec, s[74:75]
  buffer_load_dwordx4 v[88:91], v13, s[44:47], s8 offen sc1
  buffer_load_dwordx4 v[48:51], v24, s[44:47], s12 offen sc1
  s_mov_b64 exec, s[76:77]
  buffer_load_dwordx4 v[92:95], v14, s[44:47], s8 offen sc1
  buffer_load_dwordx4 v[52:55], v25, s[44:47], s12 offen sc1
  s_mov_b64 exec, s[78:79]
  buffer_load_dwordx4 v[96:99], v15, s[44:47], s8 offen sc1
  buffer_load_dwordx4 v[56:59], v26, s[44:47], s12 offen sc1
  s_mov_b64 exec, s[80:81]
  buffer_load_dwordx4 v[100:103], v16, s[44:47], s8 offen sc1
  buffer_load_dwordx4 v[60:63], v27, s[44:47], s12 offen sc1
  s_mov_b64 exec, s[82:83]
  buffer_load_dwordx4 v[104:107], v17, s[44:47], s8 offen sc1
  buffer_load_dwordx4 v[64:67], v28, s[44:47], s12 offen sc1
  s_mov_b64 exec, s[84:85]
  buffer_load_dwordx4 v[108:111], v18, s[44:47], s8 offen sc1
  buffer_load_dwordx4 v[68:71], v29, s[44:47], s12 offen sc1
  s_mov_b64 exec, -1
  s_mov_b64 s[62:63], 0
  s_waitcnt vmcnt(18)
  v_cmp_ne_u64 vcc, s[60:61], v[74:75]
  v_cmp_ne_u64 s[66:67], s[60:61], v[34:35]
  s_or_b64 s[66:67], s[66:67], vcc
  s_or_b64 s[62:63], s[62:63], s[66:67]
  s_waitcnt vmcnt(16)
  v_cmp_ne_u64 vcc, s[60:61], v[78:79]
  v_cmp_ne_u64 s[68:69], s[60:61], v[38:39]
  s_or_b64 s[68:69], s[68:69], vcc
  s_or_b64 s[62:63], s[62:63], s[68:69]
  s_waitcnt vmcnt(14)
  v_cmp_ne_u64 vcc, s[60:61], v[82:83]
  v_cmp_ne_u64 s[70:71], s[60:61], v[42:43]
  s_or_b64 s[70:71], s[70:71], vcc
  s_or_b64 s[62:63], s[62:63], s[70:71]
  s_waitcnt vmcnt(12)
  v_cmp_ne_u64 vcc, s[60:61], v[86:87]
  v_cmp_ne_u64 s[72:73], s[60:61], v[46:47]
  s_or_b64 s[72:73], s[72:73], vcc
  s_or_b64 s[62:63], s[62:63], s[72:73]
  s_waitcnt vmcnt(10)
  v_cmp_ne_u64 vcc, s[60:61], v[90:91]
  v_cmp_ne_u64 s[74:75], s[60:61], v[50:51]
  s_or_b64 s[74:75], s[74:75], vcc
  s_or_b64 s[62:63], s[62:63], s[74:75]
  s_waitcnt vmcnt(8)
  v_cmp_ne_u64 vcc, s[60:61], v[94:95]
  v_cmp_ne_u64 s[76:77], s[60:61], v[54:55]
  s_or_b64 s[76:77], s[76:77], vcc
  s_or_b64 s[62:63], s[62:63], s[76:77]
  s_waitcnt vmcnt(6)
  v_cmp_ne_u64 vcc, s[60:61], v[98:99]
  v_cmp_ne_u64 s[78:79], s[60:61], v[58:59]
  s_or_b64 s[78:79], s[78:79], vcc
  s_or_b64 s[62:63], s[62:63], s[78:79]
  s_waitcnt vmcnt(4)
  v_cmp_ne_u64 vcc, s[60:61], v[102:103]
  v_cmp_ne_u64 s[80:81], s[60:61], v[62:63]
  s_or_b64 s[80:81], s[80:81], vcc
  s_or_b64 s[62:63], s[62:63], s[80:81]
  s_waitcnt vmcnt(2)
  v_cmp_ne_u64 vcc, s[60:61], v[106:107]
  v_cmp_ne_u64 s[82:83], s[60:61], v[66:67]
  s_or_b64 s[82:83], s[82:83], vcc
  s_or_b64 s[62:63], s[62:63], s[82:83]
  s_waitcnt vmcnt(0)
  v_cmp_ne_u64 vcc, s[60:61], v[110:111]
  v_cmp_ne_u64 s[84:85], s[60:61], v[70:71]
  s_or_b64 s[84:85], s[84:85], vcc
  s_or_b64 s[62:63], s[62:63], s[84:85]
  s_cbranch_scc1 L_poll
L_final:
  v_cndmask_b32 v119, v8, v100, s[48:49]
  v_cndmask_b32 v120, v8, v104, s[50:51]
  v_cndmask_b32 v121, v8, v108, s[40:41]
  v_max3_f32 v30, v72, v76, v80
  v_max3_f32 v30, v30, v84, v88
  v_max3_f32 v30, v30, v92, v96
  v_max3_f32 v30, v30, v119, v120
  v_max_f32 v30, v30, v121
  v_mov_b32 v31, v30
  s_nop 1
  v_permlane32_swap_b32 v30, v31
  s_nop 1
  v_max_f32 v30, v30, v31
  v_mov_b32 v31, v30
  s_nop 1
  v_permlane16_swap_b32 v30, v31
  s_nop 1
  v_max_f32 v30, v30, v31
  v_sub_f32 v112, v72, v30
  v_sub_f32 v113, v76, v30
  v_sub_f32 v114, v80, v30
  v_sub_f32 v115, v84, v30
  v_sub_f32 v116, v88, v30
  v_sub_f32 v117, v92, v30
  v_sub_f32 v118, v96, v30
  v_sub_f32 v119, v119, v30
  v_sub_f32 v120, v120, v30
  v_sub_f32 v121, v121, v30
  v_exp_f32 v112, v112
  v_exp_f32 v113, v113
  v_exp_f32 v114, v114
  v_exp_f32 v115, v115
  v_exp_f32 v116, v116
  v_exp_f32 v117, v117
  v_exp_f32 v118, v118
  v_exp_f32 v119, v119
  v_exp_f32 v120, v120
  v_exp_f32 v121, v121
  s_cmp_lg_u32 s53, 0
  v_mul_f32 v2, v112, v32
  v_mul_f32 v3, v112, v33
  v_mul_f32 v4, v112, v73
  v_fmac_f32 v2, v113, v36
  v_fmac_f32 v3, v113, v37
  v_fmac_f32 v4, v113, v77
  v_fmac_f32 v2, v114, v40
  v_fmac_f32 v3, v114, v41
  v_fmac_f32 v4, v114, v81
  v_fmac_f32 v2, v115, v44
  v_fmac_f32 v3, v115, v45
  v_fmac_f32 v4, v115, v85
  v_fmac_f32 v2, v116, v48
  v_fmac_f32 v3, v116, v49
  v_fmac_f32 v4, v116, v89
  v_fmac_f32 v2, v117, v52
  v_fmac_f32 v3, v117, v53
  v_fmac_f32 v4, v117, v93
  v_fmac_f32 v2, v118, v56
  v_fmac_f32 v3, v118, v57
  v_fmac_f32 v4, v118, v97
  v_fmac_f32 v2, v119, v60
  v_fmac_f32 v3, v119, v61
  v_fmac_f32 v4, v119, v101
  v_fmac_f32 v2, v120, v64
  v_fmac_f32 v3, v120, v65
  v_fmac_f32 v4, v120, v105
  v_fmac_f32 v2, v121, v68
  v_fmac_f32 v3, v121, v69
  v_fmac_f32 v4, v121, v109
  v_mov_b32 v122, v2
  v_mov_b32 v123, v3
  v_mov_b32 v124, v4
  s_nop 1
  v_permlane32_swap_b32 v2, v122
  v_permlane32_swap_b32 v3, v123
  v_permlane32_swap_b32 v4, v124
  s_nop 1
  v_add_f32 v2, v2, v122
  v_add_f32 v3, v3, v123
  v_add_f32 v4, v4, v124
  v_mov_b32 v122, v2
  v_mov_b32 v123, v3
  v_mov_b32 v124, v4
  s_nop 1
  v_permlane16_swap_b32 v2, v122
  v_permlane16_swap_b32 v3, v123
  v_permlane16_swap_b32 v4, v124
  s_nop 1
  v_add_f32 v2, v2, v122
  v_add_f32 v3, v3, v123
  v_add_f32 v4, v4, v124
  v_rcp_f32 v31, v4
  s_nop 0
  v_fma_f32 v30, -v4, v31, 1.0
  v_fmac_f32 v31, v30, v31
  v_mul_f32 v2, v2, v31
  v_mul_f32 v3, v3, v31
  v_cvt_pk_bf16_f32 v2, v2, v3
  s_cbranch_scc1 L_dry2
  s_mov_b64 exec, 0xffff
  buffer_store_short v2, v7, s[56:59], s15 offen
  buffer_store_short_d16_hi v2, v7, s[56:59], s15 offen offset:16
L_fin1:
L_end1:
  s_endpgm
.section .rodata,"a"
.p2align 6
.amdhsa_kernel standalone__paged_block_table_kv_pagedattention__decode_kernel
  .amdhsa_next_free_vgpr 128
  .amdhsa_next_free_sgpr 86
  .amdhsa_accum_offset 128
  .amdhsa_group_segment_fixed_size 0
  .amdhsa_kernarg_size 64
  .amdhsa_user_sgpr_count 2
  .amdhsa_user_sgpr_kernarg_segment_ptr 1
  .amdhsa_system_sgpr_workgroup_id_x 1
.end_amdhsa_kernel
```
